```python
import torch

def _softmax(x, axis=-1):
    return torch.softmax(x, dim=axis)
def _gelu(x):
    return torch.nn.functional.gelu(x, approximate="tanh")
def _silu(x):
    return torch.nn.functional.silu(x)
def _sigmoid(x):
    return torch.sigmoid(x)
def _layernorm(x, axis=-1, eps=1e-5):
    m = x.mean(dim=axis, keepdim=True)
    v = x.var(dim=axis, keepdim=True, unbiased=False)
    return (x - m) / torch.sqrt(v + eps)
def _scatter_add(tgt, idx, src, axis=0):
    return tgt.clone().index_add_(axis, idx, src)
def _segment_sum(src, seg, n):
    out = torch.zeros((n,) + src.shape[1:], dtype=src.dtype)
    return out.index_add_(0, seg, src)
def _pad(x, pw):
    flat = tuple(v for pair in reversed(pw) for v in pair)
    return torch.nn.functional.pad(x, flat)

kernel_name = 'standalone__kv_cache_quant_int4_int2_kv_with_per_channel_or_per_token_scales__decode'

def setup_inputs():

    _w = (lambda a: (lambda t: t.to(torch.bfloat16) if t.is_floating_point() else t)(torch.as_tensor(a)))
    B = 1
    Sq = 1
    Skv = 16384
    Hq = 32
    Hkv = 8
    Dh = 128
    bits = 3
    G = -1
    if G <= 0 or G >= Skv:
        G = max(1, Skv // 2)
    Skv = (Skv // G) * G
    ngk = Skv // G
    qmax = (1 << bits) - 1
    return {
        "q": _w((lambda *s: torch.randn(*s, dtype=torch.bfloat16) * 1.6)(B, Hq, Sq, Dh)),
        "qk": _w(torch.randint(0, qmax + 1, (B, Hkv, Skv, Dh)).to(torch.int32)),
        "qv": _w(torch.randint(0, qmax + 1, (B, Hkv, Skv, Dh)).to(torch.int32)),
        "k_scales": _w(torch.abs((lambda *s: torch.randn(*s, dtype=torch.bfloat16) * 1.6)(B, Hkv, ngk, Dh)) * 0.05 + 0.02),
        "k_zeros": _w((lambda *s: torch.randn(*s, dtype=torch.bfloat16) * 1.6)(B, Hkv, ngk, Dh) + float(qmax) / 2.0),
        "v_scales": _w(torch.abs((lambda *s: torch.randn(*s, dtype=torch.bfloat16) * 0.05)(B, Hkv, Skv, 1)) * 0.05 + 0.02),
        "v_zeros": _w((lambda *s: torch.randn(*s, dtype=torch.bfloat16) * 0.05)(B, Hkv, Skv, 1) + float(qmax) / 2.0),
    }

def reference(q, qk, qv, k_scales, k_zeros, v_scales, v_zeros):
    B, Hq, Sq, Dh = q.shape
    Hkv, Skv = qk.shape[1], qk.shape[2]
    ngk = k_scales.shape[2]
    G = Skv // ngk
    ks = (lambda x, n, axis: torch.repeat_interleave(x, n, dim=axis))(k_scales, G, axis=2)
    kz = (lambda x, n, axis: torch.repeat_interleave(x, n, dim=axis))(k_zeros, G, axis=2)
    k = ((lambda x, dt: x.to(dt))(qk, q.dtype) - kz) * ks
    v = ((lambda x, dt: x.to(dt))(qv, q.dtype) - v_zeros) * v_scales
    rep = Hq // Hkv
    if rep > 1:
        k = (lambda x, n, axis: torch.repeat_interleave(x, n, dim=axis))(k, rep, axis=1)
        v = (lambda x, n, axis: torch.repeat_interleave(x, n, dim=axis))(v, rep, axis=1)
    scale = float(Dh) ** -0.5
    logits = torch.einsum("bhqd,bhkd->bhqk", q, k) * scale
    p = _softmax(logits, axis=-1)
    o = torch.einsum("bhqk,bhkd->bhqd", p, v)
    return o
```

```asm
; @launch grid=(256,1,1) block=(192,1,1) lds=41024
.amdgcn_target "amdgcn-amd-amdhsa--gfx950"
.text
.globl standalone__kv_cache_quant_int4_int2_kv_with_per_channel_or_per_token_scales__decode_kernel
.p2align 8
.type standalone__kv_cache_quant_int4_int2_kv_with_per_channel_or_per_token_scales__decode_kernel,@function
standalone__kv_cache_quant_int4_int2_kv_with_per_channel_or_per_token_scales__decode_kernel:
    s_cmp_ge_u32 s2, 256
    s_cbranch_scc1 L_end
    s_load_dwordx16 s[4:19], s[0:1], 0
    s_load_dwordx4 s[20:23], s[0:1], 64
    s_and_b32 s40, s2, 7
    s_lshr_b32 s41, s2, 3
    v_lshrrev_b32 v5, 6, v0
    v_and_b32 v1, 63, v0
    v_readfirstlane_b32 s50, v5
    v_lshrrev_b32 v5, 4, v1
    v_and_b32 v6, 3, v1
    v_bfe_u32 v7, v1, 2, 2
    s_nop 0
    s_cmp_eq_u32 s50, 2
    s_cbranch_scc1 L_helper
    v_lshl_add_u32 v9, v5, 2, v6
    v_lshlrev_b32 v2, 4, v9
    v_lshl_add_u32 v2, v7, 12, v2
    s_lshl_b32 s51, s50, 5
    s_add_u32 s51, s51, s41
    s_lshl_b32 s43, s51, 14
    v_add_u32 v2, s43, v2
    s_lshl_b32 s46, s40, 23
    s_mov_b32 s26, 8388608
    s_mov_b32 s27, 0x20000
    s_waitcnt lgkmcnt(0)
    s_add_u32 s24, s6, s46
    s_addc_u32 s25, s7, 0
    s_mov_b32 s57, 0
    buffer_load_dwordx4 v[124:127], v2, s[24:27], 0 offen offset:0 nt
    buffer_load_dwordx4 v[128:131], v2, s[24:27], 0 offen offset:256 nt
    buffer_load_dwordx4 v[132:135], v2, s[24:27], 0 offen offset:512 nt
    buffer_load_dwordx4 v[136:139], v2, s[24:27], 0 offen offset:768 nt
    buffer_load_dwordx4 v[140:143], v2, s[24:27], 0 offen offset:1024 nt
    buffer_load_dwordx4 v[144:147], v2, s[24:27], 0 offen offset:1280 nt
    buffer_load_dwordx4 v[148:151], v2, s[24:27], 0 offen offset:1536 nt
    buffer_load_dwordx4 v[152:155], v2, s[24:27], 0 offen offset:1792 nt
    v_and_b32 v8, 15, v1
    v_lshlrev_b32 v3, 4, v8
    v_lshl_add_u32 v3, v5, 12, v3
    v_add_u32 v3, s43, v3
    s_add_u32 s28, s8, s46
    s_addc_u32 s29, s9, 0
    v_lshlrev_b32 v11, 3, v9
    v_lshl_add_u32 v10, v7, 8, v11
    s_lshl_b32 s43, s40, 10
    v_add_u32 v10, s43, v10
    s_lshl_b32 s43, s40, 9
    v_add_u32 v11, s43, v11
    v_lshrrev_b32 v12, 2, v1
    v_mul_u32_u24 v12, 4096, v12
    v_lshl_add_u32 v12, v6, 4, v12
    s_lshl_b32 s43, s51, 6
    v_add_u32 v12, s43, v12
    s_lshl_b32 s47, s40, 15
    s_add_u32 s32, s14, s47
    s_addc_u32 s33, s15, 0
    s_mov_b32 s34, 32768
    s_mov_b32 s35, 0x20000
    s_add_u32 s36, s16, s47
    s_addc_u32 s37, s17, 0
    s_mov_b32 s38, 32768
    s_mov_b32 s39, 0x20000
    global_load_dwordx2 v[80:81], v10, s[4:5] offset:0
    global_load_dwordx2 v[82:83], v10, s[4:5] offset:128
    global_load_dwordx2 v[84:85], v11, s[10:11] offset:0
    global_load_dwordx2 v[92:93], v11, s[12:13] offset:0
    global_load_dwordx2 v[86:87], v11, s[10:11] offset:128
    global_load_dwordx2 v[94:95], v11, s[12:13] offset:128
    global_load_dwordx2 v[88:89], v11, s[10:11] offset:256
    global_load_dwordx2 v[96:97], v11, s[12:13] offset:256
    global_load_dwordx2 v[90:91], v11, s[10:11] offset:384
    global_load_dwordx2 v[98:99], v11, s[12:13] offset:384
    buffer_load_dwordx4 v[100:103], v12, s[32:35], 0 offen
    buffer_load_dwordx4 v[104:107], v12, s[36:39], 0 offen
    buffer_load_dwordx4 v[156:159], v2, s[24:27], 0 offen offset:2048 nt
    buffer_load_dwordx4 v[160:163], v2, s[24:27], 0 offen offset:2304 nt
    buffer_load_dwordx4 v[164:167], v2, s[24:27], 0 offen offset:2560 nt
    buffer_load_dwordx4 v[168:171], v2, s[24:27], 0 offen offset:2816 nt
    buffer_load_dwordx4 v[172:175], v2, s[24:27], 0 offen offset:3072 nt
    buffer_load_dwordx4 v[176:179], v2, s[24:27], 0 offen offset:3328 nt
    buffer_load_dwordx4 v[180:183], v2, s[24:27], 0 offen offset:3584 nt
    buffer_load_dwordx4 v[184:187], v2, s[24:27], 0 offen offset:3840 nt
    s_add_u32 s57, s57, 1
    s_cmp_eq_u32 s57, 8
    s_cbranch_scc1 L_tov1
    v_add_u32 v2, 1048576, v2
    s_branch L_adv1
L_tov1:
    s_mov_b32 s24, s28
    s_mov_b32 s25, s29
    v_mov_b32 v2, v3
L_adv1:
    buffer_load_dwordx4 v[188:191], v2, s[24:27], 0 offen offset:0 nt
    buffer_load_dwordx4 v[192:195], v2, s[24:27], 0 offen offset:256 nt
    buffer_load_dwordx4 v[196:199], v2, s[24:27], 0 offen offset:512 nt
    buffer_load_dwordx4 v[200:203], v2, s[24:27], 0 offen offset:768 nt
    buffer_load_dwordx4 v[204:207], v2, s[24:27], 0 offen offset:1024 nt
    buffer_load_dwordx4 v[208:211], v2, s[24:27], 0 offen offset:1280 nt
    buffer_load_dwordx4 v[212:215], v2, s[24:27], 0 offen offset:1536 nt
    buffer_load_dwordx4 v[216:219], v2, s[24:27], 0 offen offset:1792 nt
    s_lshl_b32 s43, s50, 11
    s_add_u32 s43, s43, 0
    v_lshlrev_b32 v16, 4, v1
    v_add_u32 v17, s43, v16
    v_lshlrev_b32 v4, 4, v5
    v_add_u32 v4, s43, v4
    s_mul_i32 s43, s50, 16384
    s_add_u32 s43, s43, 4096
    v_add_u32 v16, s43, v16
    s_mov_b32 s44, 0xaaaaaaaa
    s_mov_b32 s45, 0xaaaaaaaa
    s_waitcnt vmcnt(16)
    ds_write_b128 v17, v[100:103]
    ds_write_b128 v17, v[104:107] offset:1024
    v_lshrrev_b32 v5, 4, v1
    v_and_b32 v6, 3, v1
    v_bfe_u32 v7, v1, 2, 2
    v_lshl_add_u32 v116, v5, 3, v7
    v_lshlrev_b32 v116, 11, v116
    v_lshl_add_u32 v116, v6, 4, v116
    s_lshl_b32 s43, s40, 16
    s_lshl_b32 s48, s41, 6
    s_add_u32 s43, s43, s48
    s_lshl_b32 s48, s50, 13
    s_add_u32 s43, s43, s48
    s_add_u32 s43, s43, 2097152
    v_add_u32 v116, s43, v116
    v_lshlrev_b32 v118, 8, v5
    s_lshl_b32 s43, s40, 10
    s_lshl_b32 s48, s41, 3
    s_add_u32 s43, s43, s48
    s_add_u32 s43, s43, 4194304
    v_add_u32 v118, s43, v118
    v_lshrrev_b32 v120, 1, v1
    v_and_b32 v8, 1, v1
    v_lshlrev_b32 v119, 6, v120
    v_lshl_add_u32 v119, v8, 4, v119
    s_lshl_b32 s43, s40, 5
    s_add_u32 s43, s43, s41
    s_lshl_b32 s43, s43, 11
    s_lshl_b32 s48, s50, 5
    s_add_u32 s43, s43, s48
    s_add_u32 s43, s43, 2097152
    v_add_u32 v119, s43, v119
    s_lshr_b32 s48, s41, 3
    s_lshl_b32 s49, s40, 2
    s_add_u32 s49, s49, s48
    s_lshl_b32 s43, s49, 8
    s_add_u32 s43, s43, 4194304
    v_lshlrev_b32 v120, 3, v120
    v_add_u32 v120, s43, v120
    s_and_b32 s48, s41, 7
    s_lshl_b32 s48, s48, 5
    s_lshl_b32 s43, s49, 8
    s_add_u32 s43, s43, s48
    s_lshl_b32 s48, s50, 4
    s_add_u32 s43, s43, s48
    v_and_b32 v121, 1, v1
    v_lshlrev_b32 v121, 3, v121
    v_lshl_add_u32 v121, v5, 1, v121
    v_add_u32 v121, s43, v121
    v_lshlrev_b32 v122, 4, v1
    s_lshl_b32 s43, s50, 10
    s_add_u32 s48, s43, 38912
    s_xor_b32 s43, s43, 1024
    s_add_u32 s43, s43, 38912
    v_add_u32 v123, s43, v122
    v_add_u32 v122, s48, v122
    v_lshlrev_b32 v11, 4, v7
    s_lshl_b32 s43, s50, 3
    s_add_u32 s43, s43, 40960
    v_add_u32 v11, s43, v11
    v_lshlrev_b32 v117, 4, v5
    v_add_u32 v117, 40960, v117
    s_getreg_b32 s53, hwreg(HW_REG_XCC_ID, 0, 4)
    s_mul_i32 s54, s53, s53
    s_lshl_b32 s54, s54, 18
    s_lshl_b32 s53, s53, 8
    s_add_u32 s53, s53, s54
    s_add_u32 s53, s53, 1
    s_lshl_b32 s54, s53, 5
    s_mov_b32 s43, 1040356334
    v_lshlrev_b32 v48, 16, v80
    v_and_b32 v49, 0xffff0000, v80
    v_lshlrev_b32 v50, 16, v84
    v_and_b32 v51, 0xffff0000, v84
    v_mul_f32 v48, v48, v50
    v_mul_f32 v49, v49, v51
    v_mul_f32 v48, s43, v48
    v_mul_f32 v49, s43, v49
    v_cvt_pk_bf16_f32 v20, v48, v49
    v_lshlrev_b32 v48, 16, v81
    v_and_b32 v49, 0xffff0000, v81
    v_lshlrev_b32 v50, 16, v85
    v_and_b32 v51, 0xffff0000, v85
    v_mul_f32 v48, v48, v50
    v_mul_f32 v49, v49, v51
    v_mul_f32 v48, s43, v48
    v_mul_f32 v49, s43, v49
    v_cvt_pk_bf16_f32 v21, v48, v49
    v_lshlrev_b32 v48, 16, v82
    v_and_b32 v49, 0xffff0000, v82
    v_lshlrev_b32 v50, 16, v86
    v_and_b32 v51, 0xffff0000, v86
    v_mul_f32 v48, v48, v50
    v_mul_f32 v49, v49, v51
    v_mul_f32 v48, s43, v48
    v_mul_f32 v49, s43, v49
    v_cvt_pk_bf16_f32 v22, v48, v49
    v_lshlrev_b32 v48, 16, v83
    v_and_b32 v49, 0xffff0000, v83
    v_lshlrev_b32 v50, 16, v87
    v_and_b32 v51, 0xffff0000, v87
    v_mul_f32 v48, v48, v50
    v_mul_f32 v49, v49, v51
    v_mul_f32 v48, s43, v48
    v_mul_f32 v49, s43, v49
    v_cvt_pk_bf16_f32 v23, v48, v49
    s_nop 1
    v_mfma_f32_16x16x32_bf16 v[52:55], v[92:95], v[20:23], 0
    v_lshlrev_b32 v48, 16, v80
    v_and_b32 v49, 0xffff0000, v80
    v_lshlrev_b32 v50, 16, v88
    v_and_b32 v51, 0xffff0000, v88
    v_mul_f32 v48, v48, v50
    v_mul_f32 v49, v49, v51
    v_mul_f32 v48, s43, v48
    v_mul_f32 v49, s43, v49
    v_cvt_pk_bf16_f32 v24, v48, v49
    v_lshlrev_b32 v48, 16, v81
    v_and_b32 v49, 0xffff0000, v81
    v_lshlrev_b32 v50, 16, v89
    v_and_b32 v51, 0xffff0000, v89
    v_mul_f32 v48, v48, v50
    v_mul_f32 v49, v49, v51
    v_mul_f32 v48, s43, v48
    v_mul_f32 v49, s43, v49
    v_cvt_pk_bf16_f32 v25, v48, v49
    v_lshlrev_b32 v48, 16, v82
    v_and_b32 v49, 0xffff0000, v82
    v_lshlrev_b32 v50, 16, v90
    v_and_b32 v51, 0xffff0000, v90
    v_mul_f32 v48, v48, v50
    v_mul_f32 v49, v49, v51
    v_mul_f32 v48, s43, v48
    v_mul_f32 v49, s43, v49
    v_cvt_pk_bf16_f32 v26, v48, v49
    v_lshlrev_b32 v48, 16, v83
    v_and_b32 v49, 0xffff0000, v83
    v_lshlrev_b32 v50, 16, v91
    v_and_b32 v51, 0xffff0000, v91
    v_mul_f32 v48, v48, v50
    v_mul_f32 v49, v49, v51
    v_mul_f32 v48, s43, v48
    v_mul_f32 v49, s43, v49
    v_cvt_pk_bf16_f32 v27, v48, v49
    s_nop 1
    v_mfma_f32_16x16x32_bf16 v[56:59], v[96:99], v[24:27], 0
    v_cndmask_b32 v5, v52, v53, s[44:45]
    v_cndmask_b32 v6, v54, v55, s[44:45]
    s_nop 1
    v_add_f32_dpp v5, v6, v5 quad_perm:[2,3,0,1] row_mask:0xf bank_mask:0xf
    s_nop 1
    v_add_f32_dpp v14, v5, v5 quad_perm:[1,0,3,2] row_mask:0xf bank_mask:0xf
    v_cndmask_b32 v5, v56, v57, s[44:45]
    v_cndmask_b32 v6, v58, v59, s[44:45]
    s_nop 1
    v_add_f32_dpp v5, v6, v5 quad_perm:[2,3,0,1] row_mask:0xf bank_mask:0xf
    s_nop 1
    v_add_f32_dpp v15, v5, v5 quad_perm:[1,0,3,2] row_mask:0xf bank_mask:0xf
    v_mov_b32 v12, 0xff800000
    v_mov_b32 v13, 0
    v_mov_b32 v18, 0
    v_mov_b32 v80, 0
    v_mov_b32 v81, 0
    v_mov_b32 v82, 0
    v_mov_b32 v83, 0
    v_mov_b32 v84, 0
    v_mov_b32 v85, 0
    v_mov_b32 v86, 0
    v_mov_b32 v87, 0
    v_mov_b32 v88, 0
    v_mov_b32 v89, 0
    v_mov_b32 v90, 0
    v_mov_b32 v91, 0
    v_mov_b32 v92, 0
    v_mov_b32 v93, 0
    v_mov_b32 v94, 0
    v_mov_b32 v95, 0
    v_mov_b32 v96, 0
    v_mov_b32 v97, 0
    v_mov_b32 v98, 0
    v_mov_b32 v99, 0
    v_mov_b32 v100, 0
    v_mov_b32 v101, 0
    v_mov_b32 v102, 0
    v_mov_b32 v103, 0
    v_mov_b32 v104, 0
    v_mov_b32 v105, 0
    v_mov_b32 v106, 0
    v_mov_b32 v107, 0
    v_mov_b32 v108, 0
    v_mov_b32 v109, 0
    v_mov_b32 v110, 0
    v_mov_b32 v111, 0
    v_mov_b32 v112, 0
    v_mov_b32 v113, 0
    v_mov_b32 v114, 0
    v_mov_b32 v115, 0
    v_mov_b32 v19, v14
    s_mov_b32 s42, 0
L_kloop:
    s_cmp_eq_u32 s42, 4
    s_cbranch_scc0 L_nosw
    v_mov_b32 v20, v24
    v_mov_b32 v21, v25
    v_mov_b32 v22, v26
    v_mov_b32 v23, v27
    v_mov_b32 v19, v15
L_nosw:
    s_waitcnt vmcnt(22)
    buffer_load_dwordx4 v[220:223], v2, s[24:27], 0 offen offset:2048 nt
    buffer_load_dwordx4 v[224:227], v2, s[24:27], 0 offen offset:2304 nt
    v_cvt_f32_i32 v124, v124
    v_cvt_f32_i32 v125, v125
    v_cvt_f32_i32 v126, v126
    v_cvt_f32_i32 v127, v127
    v_cvt_f32_i32 v128, v128
    v_cvt_f32_i32 v129, v129
    v_cvt_f32_i32 v130, v130
    v_cvt_f32_i32 v131, v131
    v_cvt_pk_bf16_f32 v48, v124, v125
    v_cvt_pk_bf16_f32 v49, v126, v127
    v_cvt_pk_bf16_f32 v50, v128, v129
    v_cvt_pk_bf16_f32 v51, v130, v131
    s_nop 1
    v_mfma_f32_16x16x32_bf16 v[56:59], v[48:51], v[20:23], 0
    s_waitcnt vmcnt(22)
    buffer_load_dwordx4 v[228:231], v2, s[24:27], 0 offen offset:2560 nt
    buffer_load_dwordx4 v[232:235], v2, s[24:27], 0 offen offset:2816 nt
    v_cvt_f32_i32 v132, v132
    v_cvt_f32_i32 v133, v133
    v_cvt_f32_i32 v134, v134
    v_cvt_f32_i32 v135, v135
    v_cvt_f32_i32 v136, v136
    v_cvt_f32_i32 v137, v137
    v_cvt_f32_i32 v138, v138
    v_cvt_f32_i32 v139, v139
    v_cndmask_b32 v5, v56, v57, s[44:45]
    v_cndmask_b32 v6, v58, v59, s[44:45]
    v_cvt_pk_bf16_f32 v52, v132, v133
    v_cvt_pk_bf16_f32 v53, v134, v135
    v_add_f32_dpp v5, v6, v5 quad_perm:[2,3,0,1] row_mask:0xf bank_mask:0xf
    v_cvt_pk_bf16_f32 v54, v136, v137
    v_cvt_pk_bf16_f32 v55, v138, v139
    v_add_f32_dpp v36, v5, v5 quad_perm:[1,0,3,2] row_mask:0xf bank_mask:0xf
    v_mov_b32 v7, 0xff800000
    v_mfma_f32_16x16x32_bf16 v[60:63], v[52:55], v[20:23], 0
    s_waitcnt vmcnt(22)
    buffer_load_dwordx4 v[236:239], v2, s[24:27], 0 offen offset:3072 nt
    buffer_load_dwordx4 v[240:243], v2, s[24:27], 0 offen offset:3328 nt
    v_cvt_f32_i32 v140, v140
    v_cvt_f32_i32 v141, v141
    v_cvt_f32_i32 v142, v142
    v_cvt_f32_i32 v143, v143
    v_cvt_f32_i32 v144, v144
    v_cvt_f32_i32 v145, v145
    v_cvt_f32_i32 v146, v146
    v_cvt_f32_i32 v147, v147
    v_cndmask_b32 v5, v60, v61, s[44:45]
    v_cndmask_b32 v6, v62, v63, s[44:45]
    v_cvt_pk_bf16_f32 v48, v140, v141
    v_cvt_pk_bf16_f32 v49, v142, v143
    v_add_f32_dpp v5, v6, v5 quad_perm:[2,3,0,1] row_mask:0xf bank_mask:0xf
    v_cvt_pk_bf16_f32 v50, v144, v145
    v_cvt_pk_bf16_f32 v51, v146, v147
    v_add_f32_dpp v37, v5, v5 quad_perm:[1,0,3,2] row_mask:0xf bank_mask:0xf
    v_max_f32 v7, v7, v36
    v_mfma_f32_16x16x32_bf16 v[56:59], v[48:51], v[20:23], 0
    s_waitcnt vmcnt(22)
    buffer_load_dwordx4 v[244:247], v2, s[24:27], 0 offen offset:3584 nt
    buffer_load_dwordx4 v[248:251], v2, s[24:27], 0 offen offset:3840 nt
    v_cvt_f32_i32 v148, v148
    v_cvt_f32_i32 v149, v149
    v_cvt_f32_i32 v150, v150
    v_cvt_f32_i32 v151, v151
    v_cvt_f32_i32 v152, v152
    v_cvt_f32_i32 v153, v153
    v_cvt_f32_i32 v154, v154
    v_cvt_f32_i32 v155, v155
    v_cndmask_b32 v5, v56, v57, s[44:45]
    v_cndmask_b32 v6, v58, v59, s[44:45]
    v_cvt_pk_bf16_f32 v52, v148, v149
    v_cvt_pk_bf16_f32 v53, v150, v151
    v_add_f32_dpp v5, v6, v5 quad_perm:[2,3,0,1] row_mask:0xf bank_mask:0xf
    v_cvt_pk_bf16_f32 v54, v152, v153
    v_cvt_pk_bf16_f32 v55, v154, v155
    v_add_f32_dpp v38, v5, v5 quad_perm:[1,0,3,2] row_mask:0xf bank_mask:0xf
    v_max_f32 v7, v7, v37
    v_mfma_f32_16x16x32_bf16 v[60:63], v[52:55], v[20:23], 0
    s_waitcnt vmcnt(22)
    s_add_u32 s57, s57, 1
    s_cmp_eq_u32 s57, 8
    s_cbranch_scc1 L_tov2
    v_add_u32 v2, 1048576, v2
    s_branch L_adv2
L_tov2:
    s_mov_b32 s24, s28
    s_mov_b32 s25, s29
    v_mov_b32 v2, v3
L_adv2:
    buffer_load_dwordx4 v[124:127], v2, s[24:27], 0 offen offset:0 nt
    buffer_load_dwordx4 v[128:131], v2, s[24:27], 0 offen offset:256 nt
    v_cvt_f32_i32 v156, v156
    v_cvt_f32_i32 v157, v157
    v_cvt_f32_i32 v158, v158
    v_cvt_f32_i32 v159, v159
    v_cvt_f32_i32 v160, v160
    v_cvt_f32_i32 v161, v161
    v_cvt_f32_i32 v162, v162
    v_cvt_f32_i32 v163, v163
    v_cndmask_b32 v5, v60, v61, s[44:45]
    v_cndmask_b32 v6, v62, v63, s[44:45]
    v_cvt_pk_bf16_f32 v48, v156, v157
    v_cvt_pk_bf16_f32 v49, v158, v159
    v_add_f32_dpp v5, v6, v5 quad_perm:[2,3,0,1] row_mask:0xf bank_mask:0xf
    v_cvt_pk_bf16_f32 v50, v160, v161
    v_cvt_pk_bf16_f32 v51, v162, v163
    v_add_f32_dpp v39, v5, v5 quad_perm:[1,0,3,2] row_mask:0xf bank_mask:0xf
    v_max_f32 v7, v7, v38
    v_mfma_f32_16x16x32_bf16 v[56:59], v[48:51], v[20:23], 0
    s_waitcnt vmcnt(22)
    buffer_load_dwordx4 v[132:135], v2, s[24:27], 0 offen offset:512 nt
    buffer_load_dwordx4 v[136:139], v2, s[24:27], 0 offen offset:768 nt
    v_cvt_f32_i32 v164, v164
    v_cvt_f32_i32 v165, v165
    v_cvt_f32_i32 v166, v166
    v_cvt_f32_i32 v167, v167
    v_cvt_f32_i32 v168, v168
    v_cvt_f32_i32 v169, v169
    v_cvt_f32_i32 v170, v170
    v_cvt_f32_i32 v171, v171
    v_cndmask_b32 v5, v56, v57, s[44:45]
    v_cndmask_b32 v6, v58, v59, s[44:45]
    v_cvt_pk_bf16_f32 v52, v164, v165
    v_cvt_pk_bf16_f32 v53, v166, v167
    v_add_f32_dpp v5, v6, v5 quad_perm:[2,3,0,1] row_mask:0xf bank_mask:0xf
    v_cvt_pk_bf16_f32 v54, v168, v169
    v_cvt_pk_bf16_f32 v55, v170, v171
    v_add_f32_dpp v40, v5, v5 quad_perm:[1,0,3,2] row_mask:0xf bank_mask:0xf
    v_max_f32 v7, v7, v39
    v_mfma_f32_16x16x32_bf16 v[60:63], v[52:55], v[20:23], 0
    s_waitcnt vmcnt(22)
    buffer_load_dwordx4 v[140:143], v2, s[24:27], 0 offen offset:1024 nt
    buffer_load_dwordx4 v[144:147], v2, s[24:27], 0 offen offset:1280 nt
    v_cvt_f32_i32 v172, v172
    v_cvt_f32_i32 v173, v173
    v_cvt_f32_i32 v174, v174
    v_cvt_f32_i32 v175, v175
    v_cvt_f32_i32 v176, v176
    v_cvt_f32_i32 v177, v177
    v_cvt_f32_i32 v178, v178
    v_cvt_f32_i32 v179, v179
    v_cndmask_b32 v5, v60, v61, s[44:45]
    v_cndmask_b32 v6, v62, v63, s[44:45]
    v_cvt_pk_bf16_f32 v48, v172, v173
    v_cvt_pk_bf16_f32 v49, v174, v175
    v_add_f32_dpp v5, v6, v5 quad_perm:[2,3,0,1] row_mask:0xf bank_mask:0xf
    v_cvt_pk_bf16_f32 v50, v176, v177
    v_cvt_pk_bf16_f32 v51, v178, v179
    v_add_f32_dpp v41, v5, v5 quad_perm:[1,0,3,2] row_mask:0xf bank_mask:0xf
    v_max_f32 v7, v7, v40
    v_mfma_f32_16x16x32_bf16 v[56:59], v[48:51], v[20:23], 0
    s_waitcnt vmcnt(22)
    buffer_load_dwordx4 v[148:151], v2, s[24:27], 0 offen offset:1536 nt
    buffer_load_dwordx4 v[152:155], v2, s[24:27], 0 offen offset:1792 nt
    v_cvt_f32_i32 v180, v180
    v_cvt_f32_i32 v181, v181
    v_cvt_f32_i32 v182, v182
    v_cvt_f32_i32 v183, v183
    v_cvt_f32_i32 v184, v184
    v_cvt_f32_i32 v185, v185
    v_cvt_f32_i32 v186, v186
    v_cvt_f32_i32 v187, v187
    v_cndmask_b32 v5, v56, v57, s[44:45]
    v_cndmask_b32 v6, v58, v59, s[44:45]
    v_cvt_pk_bf16_f32 v52, v180, v181
    v_cvt_pk_bf16_f32 v53, v182, v183
    v_add_f32_dpp v5, v6, v5 quad_perm:[2,3,0,1] row_mask:0xf bank_mask:0xf
    v_cvt_pk_bf16_f32 v54, v184, v185
    v_cvt_pk_bf16_f32 v55, v186, v187
    v_add_f32_dpp v42, v5, v5 quad_perm:[1,0,3,2] row_mask:0xf bank_mask:0xf
    v_max_f32 v7, v7, v41
    v_mfma_f32_16x16x32_bf16 v[60:63], v[52:55], v[20:23], 0
    ds_write_b128 v16, v[36:39]
    v_max_f32 v7, v7, v42
    s_nop 5
    v_cndmask_b32 v5, v60, v61, s[44:45]
    v_cndmask_b32 v6, v62, v63, s[44:45]
    v_sub_f32 v7, v7, v19
    v_max_f32 v12, v12, v7
    v_add_f32_dpp v5, v6, v5 quad_perm:[2,3,0,1] row_mask:0xf bank_mask:0xf
    s_nop 1
    v_add_f32_dpp v43, v5, v5 quad_perm:[1,0,3,2] row_mask:0xf bank_mask:0xf
    v_sub_f32 v7, v43, v19
    ds_write_b128 v16, v[40:43] offset:1024
    v_max_f32 v12, v12, v7
    v_add_u32 v16, 2048, v16
    s_waitcnt vmcnt(22)
    buffer_load_dwordx4 v[156:159], v2, s[24:27], 0 offen offset:2048 nt
    buffer_load_dwordx4 v[160:163], v2, s[24:27], 0 offen offset:2304 nt
    v_cvt_f32_i32 v188, v188
    v_cvt_f32_i32 v189, v189
    v_cvt_f32_i32 v190, v190
    v_cvt_f32_i32 v191, v191
    v_cvt_f32_i32 v192, v192
    v_cvt_f32_i32 v193, v193
    v_cvt_f32_i32 v194, v194
    v_cvt_f32_i32 v195, v195
    v_cvt_pk_bf16_f32 v48, v188, v189
    v_cvt_pk_bf16_f32 v49, v190, v191
    v_cvt_pk_bf16_f32 v50, v192, v193
    v_cvt_pk_bf16_f32 v51, v194, v195
    s_nop 1
    v_mfma_f32_16x16x32_bf16 v[56:59], v[48:51], v[20:23], 0
    s_waitcnt vmcnt(22)
    buffer_load_dwordx4 v[164:167], v2, s[24:27], 0 offen offset:2560 nt
    buffer_load_dwordx4 v[168:171], v2, s[24:27], 0 offen offset:2816 nt
    v_cvt_f32_i32 v196, v196
    v_cvt_f32_i32 v197, v197
    v_cvt_f32_i32 v198, v198
    v_cvt_f32_i32 v199, v199
    v_cvt_f32_i32 v200, v200
    v_cvt_f32_i32 v201, v201
    v_cvt_f32_i32 v202, v202
    v_cvt_f32_i32 v203, v203
    v_cndmask_b32 v5, v56, v57, s[44:45]
    v_cndmask_b32 v6, v58, v59, s[44:45]
    v_cvt_pk_bf16_f32 v52, v196, v197
    v_cvt_pk_bf16_f32 v53, v198, v199
    v_add_f32_dpp v5, v6, v5 quad_perm:[2,3,0,1] row_mask:0xf bank_mask:0xf
    v_cvt_pk_bf16_f32 v54, v200, v201
    v_cvt_pk_bf16_f32 v55, v202, v203
    v_add_f32_dpp v36, v5, v5 quad_perm:[1,0,3,2] row_mask:0xf bank_mask:0xf
    v_mov_b32 v7, 0xff800000
    v_mfma_f32_16x16x32_bf16 v[60:63], v[52:55], v[20:23], 0
    s_waitcnt vmcnt(22)
    buffer_load_dwordx4 v[172:175], v2, s[24:27], 0 offen offset:3072 nt
    buffer_load_dwordx4 v[176:179], v2, s[24:27], 0 offen offset:3328 nt
    v_cvt_f32_i32 v204, v204
    v_cvt_f32_i32 v205, v205
    v_cvt_f32_i32 v206, v206
    v_cvt_f32_i32 v207, v207
    v_cvt_f32_i32 v208, v208
    v_cvt_f32_i32 v209, v209
    v_cvt_f32_i32 v210, v210
    v_cvt_f32_i32 v211, v211
    v_cndmask_b32 v5, v60, v61, s[44:45]
    v_cndmask_b32 v6, v62, v63, s[44:45]
    v_cvt_pk_bf16_f32 v48, v204, v205
    v_cvt_pk_bf16_f32 v49, v206, v207
    v_add_f32_dpp v5, v6, v5 quad_perm:[2,3,0,1] row_mask:0xf bank_mask:0xf
    v_cvt_pk_bf16_f32 v50, v208, v209
    v_cvt_pk_bf16_f32 v51, v210, v211
    v_add_f32_dpp v37, v5, v5 quad_perm:[1,0,3,2] row_mask:0xf bank_mask:0xf
    v_max_f32 v7, v7, v36
    v_mfma_f32_16x16x32_bf16 v[56:59], v[48:51], v[20:23], 0
    s_waitcnt vmcnt(22)
    buffer_load_dwordx4 v[180:183], v2, s[24:27], 0 offen offset:3584 nt
    buffer_load_dwordx4 v[184:187], v2, s[24:27], 0 offen offset:3840 nt
    v_cvt_f32_i32 v212, v212
    v_cvt_f32_i32 v213, v213
    v_cvt_f32_i32 v214, v214
    v_cvt_f32_i32 v215, v215
    v_cvt_f32_i32 v216, v216
    v_cvt_f32_i32 v217, v217
    v_cvt_f32_i32 v218, v218
    v_cvt_f32_i32 v219, v219
    v_cndmask_b32 v5, v56, v57, s[44:45]
    v_cndmask_b32 v6, v58, v59, s[44:45]
    v_cvt_pk_bf16_f32 v52, v212, v213
    v_cvt_pk_bf16_f32 v53, v214, v215
    v_add_f32_dpp v5, v6, v5 quad_perm:[2,3,0,1] row_mask:0xf bank_mask:0xf
    v_cvt_pk_bf16_f32 v54, v216, v217
    v_cvt_pk_bf16_f32 v55, v218, v219
    v_add_f32_dpp v38, v5, v5 quad_perm:[1,0,3,2] row_mask:0xf bank_mask:0xf
    v_max_f32 v7, v7, v37
    v_mfma_f32_16x16x32_bf16 v[60:63], v[52:55], v[20:23], 0
    s_waitcnt vmcnt(22)
    s_add_u32 s57, s57, 1
    s_cmp_eq_u32 s57, 8
    s_cbranch_scc1 L_tov3
    v_add_u32 v2, 1048576, v2
    s_branch L_adv3
L_tov3:
    s_mov_b32 s24, s28
    s_mov_b32 s25, s29
    v_mov_b32 v2, v3
L_adv3:
    buffer_load_dwordx4 v[188:191], v2, s[24:27], 0 offen offset:0 nt
    buffer_load_dwordx4 v[192:195], v2, s[24:27], 0 offen offset:256 nt
    v_cvt_f32_i32 v220, v220
    v_cvt_f32_i32 v221, v221
    v_cvt_f32_i32 v222, v222
    v_cvt_f32_i32 v223, v223
    v_cvt_f32_i32 v224, v224
    v_cvt_f32_i32 v225, v225
    v_cvt_f32_i32 v226, v226
    v_cvt_f32_i32 v227, v227
    v_cndmask_b32 v5, v60, v61, s[44:45]
    v_cndmask_b32 v6, v62, v63, s[44:45]
    v_cvt_pk_bf16_f32 v48, v220, v221
    v_cvt_pk_bf16_f32 v49, v222, v223
    v_add_f32_dpp v5, v6, v5 quad_perm:[2,3,0,1] row_mask:0xf bank_mask:0xf
    v_cvt_pk_bf16_f32 v50, v224, v225
    v_cvt_pk_bf16_f32 v51, v226, v227
    v_add_f32_dpp v39, v5, v5 quad_perm:[1,0,3,2] row_mask:0xf bank_mask:0xf
    v_max_f32 v7, v7, v38
    v_mfma_f32_16x16x32_bf16 v[56:59], v[48:51], v[20:23], 0
    s_waitcnt vmcnt(22)
    buffer_load_dwordx4 v[196:199], v2, s[24:27], 0 offen offset:512 nt
    buffer_load_dwordx4 v[200:203], v2, s[24:27], 0 offen offset:768 nt
    v_cvt_f32_i32 v228, v228
    v_cvt_f32_i32 v229, v229
    v_cvt_f32_i32 v230, v230
    v_cvt_f32_i32 v231, v231
    v_cvt_f32_i32 v232, v232
    v_cvt_f32_i32 v233, v233
    v_cvt_f32_i32 v234, v234
    v_cvt_f32_i32 v235, v235
    v_cndmask_b32 v5, v56, v57, s[44:45]
    v_cndmask_b32 v6, v58, v59, s[44:45]
    v_cvt_pk_bf16_f32 v52, v228, v229
    v_cvt_pk_bf16_f32 v53, v230, v231
    v_add_f32_dpp v5, v6, v5 quad_perm:[2,3,0,1] row_mask:0xf bank_mask:0xf
    v_cvt_pk_bf16_f32 v54, v232, v233
    v_cvt_pk_bf16_f32 v55, v234, v235
    v_add_f32_dpp v40, v5, v5 quad_perm:[1,0,3,2] row_mask:0xf bank_mask:0xf
    v_max_f32 v7, v7, v39
    v_mfma_f32_16x16x32_bf16 v[60:63], v[52:55], v[20:23], 0
    s_waitcnt vmcnt(22)
    buffer_load_dwordx4 v[204:207], v2, s[24:27], 0 offen offset:1024 nt
    buffer_load_dwordx4 v[208:211], v2, s[24:27], 0 offen offset:1280 nt
    v_cvt_f32_i32 v236, v236
    v_cvt_f32_i32 v237, v237
    v_cvt_f32_i32 v238, v238
    v_cvt_f32_i32 v239, v239
    v_cvt_f32_i32 v240, v240
    v_cvt_f32_i32 v241, v241
    v_cvt_f32_i32 v242, v242
    v_cvt_f32_i32 v243, v243
    v_cndmask_b32 v5, v60, v61, s[44:45]
    v_cndmask_b32 v6, v62, v63, s[44:45]
    v_cvt_pk_bf16_f32 v48, v236, v237
    v_cvt_pk_bf16_f32 v49, v238, v239
    v_add_f32_dpp v5, v6, v5 quad_perm:[2,3,0,1] row_mask:0xf bank_mask:0xf
    v_cvt_pk_bf16_f32 v50, v240, v241
    v_cvt_pk_bf16_f32 v51, v242, v243
    v_add_f32_dpp v41, v5, v5 quad_perm:[1,0,3,2] row_mask:0xf bank_mask:0xf
    v_max_f32 v7, v7, v40
    v_mfma_f32_16x16x32_bf16 v[56:59], v[48:51], v[20:23], 0
    s_waitcnt vmcnt(22)
    buffer_load_dwordx4 v[212:215], v2, s[24:27], 0 offen offset:1536 nt
    buffer_load_dwordx4 v[216:219], v2, s[24:27], 0 offen offset:1792 nt
    v_cvt_f32_i32 v244, v244
    v_cvt_f32_i32 v245, v245
    v_cvt_f32_i32 v246, v246
    v_cvt_f32_i32 v247, v247
    v_cvt_f32_i32 v248, v248
    v_cvt_f32_i32 v249, v249
    v_cvt_f32_i32 v250, v250
    v_cvt_f32_i32 v251, v251
    v_cndmask_b32 v5, v56, v57, s[44:45]
    v_cndmask_b32 v6, v58, v59, s[44:45]
    v_cvt_pk_bf16_f32 v52, v244, v245
    v_cvt_pk_bf16_f32 v53, v246, v247
    v_add_f32_dpp v5, v6, v5 quad_perm:[2,3,0,1] row_mask:0xf bank_mask:0xf
    v_cvt_pk_bf16_f32 v54, v248, v249
    v_cvt_pk_bf16_f32 v55, v250, v251
    v_add_f32_dpp v42, v5, v5 quad_perm:[1,0,3,2] row_mask:0xf bank_mask:0xf
    v_max_f32 v7, v7, v41
    v_mfma_f32_16x16x32_bf16 v[60:63], v[52:55], v[20:23], 0
    ds_write_b128 v16, v[36:39]
    v_max_f32 v7, v7, v42
    s_nop 5
    v_cndmask_b32 v5, v60, v61, s[44:45]
    v_cndmask_b32 v6, v62, v63, s[44:45]
    v_sub_f32 v7, v7, v19
    v_max_f32 v12, v12, v7
    v_add_f32_dpp v5, v6, v5 quad_perm:[2,3,0,1] row_mask:0xf bank_mask:0xf
    s_nop 1
    v_add_f32_dpp v43, v5, v5 quad_perm:[1,0,3,2] row_mask:0xf bank_mask:0xf
    v_sub_f32 v7, v43, v19
    ds_write_b128 v16, v[40:43] offset:1024
    v_max_f32 v12, v12, v7
    v_add_u32 v16, 2048, v16
    s_add_u32 s42, s42, 2
    s_cmp_lt_u32 s42, 8
    s_cbranch_scc1 L_kloop
    v_subrev_u32 v16, 16384, v16
    v_mov_b32 v19, v14
    v_mov_b32 v5, v12
    ds_read_b128 v[36:39], v16
    ds_read_b128 v[40:43], v16 offset:1024
    v_permlane16_swap_b32 v12, v5
    v_max_f32 v12, v12, v5
    ds_read_b128 v[28:31], v4
    v_mov_b32 v5, v12
    ds_read_b128 v[32:35], v4 offset:1024
    v_add_u32 v16, 2048, v16
    v_permlane32_swap_b32 v12, v5
    v_max_f32 v12, v12, v5
    s_mov_b32 s42, 0
L_vloop:
    s_cmp_eq_u32 s42, 4
    s_cbranch_scc0 L_nochk
    s_lshl_b32 s43, s40, 5
    v_mov_b32 v5, s43
    global_load_dword v18, v5, s[20:21] sc1
L_nochk:
    v_add_f32 v17, v12, v19
    s_waitcnt lgkmcnt(0)
    v_sub_f32 v36, v36, v17
    v_sub_f32 v37, v37, v17
    v_sub_f32 v38, v38, v17
    v_sub_f32 v39, v39, v17
    v_sub_f32 v40, v40, v17
    v_sub_f32 v41, v41, v17
    v_sub_f32 v42, v42, v17
    v_sub_f32 v43, v43, v17
    v_exp_f32 v36, v36
    v_lshlrev_b32 v48, 16, v28
    v_exp_f32 v37, v37
    v_and_b32 v49, 0xffff0000, v28
    v_exp_f32 v38, v38
    v_lshlrev_b32 v50, 16, v29
    v_exp_f32 v39, v39
    v_and_b32 v51, 0xffff0000, v29
    v_exp_f32 v40, v40
    v_lshlrev_b32 v52, 16, v30
    v_exp_f32 v41, v41
    v_and_b32 v53, 0xffff0000, v30
    v_exp_f32 v42, v42
    v_lshlrev_b32 v54, 16, v31
    v_exp_f32 v43, v43
    v_and_b32 v55, 0xffff0000, v31
    v_mul_f32 v48, v48, v36
    v_mul_f32 v49, v49, v37
    v_add_f32 v13, v13, v36
    v_cvt_pk_bf16_f32 v44, v48, v49
    v_add_f32 v13, v13, v37
    v_mul_f32 v50, v50, v38
    v_mul_f32 v51, v51, v39
    v_add_f32 v13, v13, v38
    v_cvt_pk_bf16_f32 v45, v50, v51
    v_add_f32 v13, v13, v39
    v_mul_f32 v52, v52, v40
    v_mul_f32 v53, v53, v41
    v_add_f32 v13, v13, v40
    v_cvt_pk_bf16_f32 v46, v52, v53
    v_add_f32 v13, v13, v41
    v_mul_f32 v54, v54, v42
    v_mul_f32 v55, v55, v43
    v_add_f32 v13, v13, v42
    v_cvt_pk_bf16_f32 v47, v54, v55
    v_add_f32 v13, v13, v43
    v_add_u32 v4, 64, v4
    ds_read_b128 v[36:39], v16
    v_mfma_f32_16x16x32_bf16 v[112:115], v[44:47], v[32:35], v[112:115]
    ds_read_b128 v[40:43], v16 offset:1024
    ds_read_b128 v[28:31], v4
    s_waitcnt vmcnt(20)
    buffer_load_dwordx4 v[220:223], v2, s[24:27], 0 offen offset:2048 nt
    buffer_load_dwordx4 v[224:227], v2, s[24:27], 0 offen offset:2304 nt
    buffer_load_dwordx4 v[228:231], v2, s[24:27], 0 offen offset:2560 nt
    buffer_load_dwordx4 v[232:235], v2, s[24:27], 0 offen offset:2816 nt
    v_cvt_f32_i32 v124, v124
    v_cvt_f32_i32 v132, v132
    v_cvt_f32_i32 v125, v125
    v_cvt_f32_i32 v133, v133
    v_cvt_f32_i32 v126, v126
    v_cvt_f32_i32 v134, v134
    v_cvt_f32_i32 v127, v127
    v_cvt_f32_i32 v135, v135
    v_cvt_f32_i32 v128, v128
    v_cvt_f32_i32 v136, v136
    v_cvt_f32_i32 v129, v129
    v_cvt_f32_i32 v137, v137
    v_cvt_f32_i32 v130, v130
    v_cvt_f32_i32 v138, v138
    v_cvt_f32_i32 v131, v131
    v_cvt_f32_i32 v139, v139
    ds_read_b128 v[32:35], v4 offset:1024
    v_add_u32 v16, 2048, v16
    v_cvt_pk_bf16_f32 v48, v124, v132
    v_cvt_pk_bf16_f32 v52, v125, v133
    v_cvt_pk_bf16_f32 v56, v126, v134
    v_cvt_pk_bf16_f32 v60, v127, v135
    v_cvt_pk_bf16_f32 v64, v128, v136
    v_cvt_pk_bf16_f32 v68, v129, v137
    v_cvt_pk_bf16_f32 v72, v130, v138
    v_cvt_pk_bf16_f32 v76, v131, v139
    s_waitcnt vmcnt(20)
    buffer_load_dwordx4 v[236:239], v2, s[24:27], 0 offen offset:3072 nt
    buffer_load_dwordx4 v[240:243], v2, s[24:27], 0 offen offset:3328 nt
    buffer_load_dwordx4 v[244:247], v2, s[24:27], 0 offen offset:3584 nt
    buffer_load_dwordx4 v[248:251], v2, s[24:27], 0 offen offset:3840 nt
    v_cvt_f32_i32 v140, v140
    v_cvt_f32_i32 v148, v148
    v_cvt_f32_i32 v141, v141
    v_cvt_f32_i32 v149, v149
    v_cvt_f32_i32 v142, v142
    v_cvt_f32_i32 v150, v150
    v_cvt_f32_i32 v143, v143
    v_cvt_f32_i32 v151, v151
    v_cvt_f32_i32 v144, v144
    v_cvt_f32_i32 v152, v152
    v_cvt_f32_i32 v145, v145
    v_cvt_f32_i32 v153, v153
    v_cvt_f32_i32 v146, v146
    v_cvt_f32_i32 v154, v154
    v_cvt_f32_i32 v147, v147
    v_cvt_f32_i32 v155, v155
    v_cvt_pk_bf16_f32 v49, v140, v148
    v_cvt_pk_bf16_f32 v53, v141, v149
    v_cvt_pk_bf16_f32 v57, v142, v150
    v_cvt_pk_bf16_f32 v61, v143, v151
    v_cvt_pk_bf16_f32 v65, v144, v152
    v_cvt_pk_bf16_f32 v69, v145, v153
    v_cvt_pk_bf16_f32 v73, v146, v154
    v_cvt_pk_bf16_f32 v77, v147, v155
    s_waitcnt vmcnt(20)
    v_add_u32 v2, 1048576, v2
    buffer_load_dwordx4 v[124:127], v2, s[24:27], 0 offen offset:0 nt
    buffer_load_dwordx4 v[128:131], v2, s[24:27], 0 offen offset:256 nt
    buffer_load_dwordx4 v[132:135], v2, s[24:27], 0 offen offset:512 nt
    buffer_load_dwordx4 v[136:139], v2, s[24:27], 0 offen offset:768 nt
    v_cvt_f32_i32 v156, v156
    v_cvt_f32_i32 v164, v164
    v_cvt_f32_i32 v157, v157
    v_cvt_f32_i32 v165, v165
    v_cvt_f32_i32 v158, v158
    v_cvt_f32_i32 v166, v166
    v_cvt_f32_i32 v159, v159
    v_cvt_f32_i32 v167, v167
    v_cvt_f32_i32 v160, v160
    v_cvt_f32_i32 v168, v168
    v_cvt_f32_i32 v161, v161
    v_cvt_f32_i32 v169, v169
    v_cvt_f32_i32 v162, v162
    v_cvt_f32_i32 v170, v170
    v_cvt_f32_i32 v163, v163
    v_cvt_f32_i32 v171, v171
    v_cvt_pk_bf16_f32 v50, v156, v164
    v_cvt_pk_bf16_f32 v54, v157, v165
    v_cvt_pk_bf16_f32 v58, v158, v166
    v_cvt_pk_bf16_f32 v62, v159, v167
    v_cvt_pk_bf16_f32 v66, v160, v168
    v_cvt_pk_bf16_f32 v70, v161, v169
    v_cvt_pk_bf16_f32 v74, v162, v170
    v_cvt_pk_bf16_f32 v78, v163, v171
    s_waitcnt vmcnt(20)
    buffer_load_dwordx4 v[140:143], v2, s[24:27], 0 offen offset:1024 nt
    buffer_load_dwordx4 v[144:147], v2, s[24:27], 0 offen offset:1280 nt
    buffer_load_dwordx4 v[148:151], v2, s[24:27], 0 offen offset:1536 nt
    buffer_load_dwordx4 v[152:155], v2, s[24:27], 0 offen offset:1792 nt
    v_cvt_f32_i32 v172, v172
    v_cvt_f32_i32 v180, v180
    v_cvt_f32_i32 v173, v173
    v_cvt_f32_i32 v181, v181
    v_cvt_f32_i32 v174, v174
    v_cvt_f32_i32 v182, v182
    v_cvt_f32_i32 v175, v175
    v_cvt_f32_i32 v183, v183
    v_cvt_f32_i32 v176, v176
    v_cvt_f32_i32 v184, v184
    v_cvt_f32_i32 v177, v177
    v_cvt_f32_i32 v185, v185
    v_cvt_f32_i32 v178, v178
    v_cvt_f32_i32 v186, v186
    v_cvt_f32_i32 v179, v179
    v_cvt_f32_i32 v187, v187
    v_cvt_pk_bf16_f32 v51, v172, v180
    v_cvt_pk_bf16_f32 v55, v173, v181
    v_cvt_pk_bf16_f32 v59, v174, v182
    v_cvt_pk_bf16_f32 v63, v175, v183
    v_cvt_pk_bf16_f32 v67, v176, v184
    v_cvt_pk_bf16_f32 v71, v177, v185
    v_cvt_pk_bf16_f32 v75, v178, v186
    v_cvt_pk_bf16_f32 v79, v179, v187
    v_mfma_f32_16x16x32_bf16 v[80:83], v[44:47], v[48:51], v[80:83]
    v_mfma_f32_16x16x32_bf16 v[84:87], v[44:47], v[52:55], v[84:87]
    v_mfma_f32_16x16x32_bf16 v[88:91], v[44:47], v[56:59], v[88:91]
    v_mfma_f32_16x16x32_bf16 v[92:95], v[44:47], v[60:63], v[92:95]
    v_mfma_f32_16x16x32_bf16 v[96:99], v[44:47], v[64:67], v[96:99]
    v_mfma_f32_16x16x32_bf16 v[100:103], v[44:47], v[68:71], v[100:103]
    v_mfma_f32_16x16x32_bf16 v[104:107], v[44:47], v[72:75], v[104:107]
    v_mfma_f32_16x16x32_bf16 v[108:111], v[44:47], v[76:79], v[108:111]
    v_add_f32 v17, v12, v19
    s_waitcnt lgkmcnt(0)
    v_sub_f32 v36, v36, v17
    v_sub_f32 v37, v37, v17
    v_sub_f32 v38, v38, v17
    v_sub_f32 v39, v39, v17
    v_sub_f32 v40, v40, v17
    v_sub_f32 v41, v41, v17
    v_sub_f32 v42, v42, v17
    v_sub_f32 v43, v43, v17
    v_exp_f32 v36, v36
    v_lshlrev_b32 v48, 16, v28
    v_exp_f32 v37, v37
    v_and_b32 v49, 0xffff0000, v28
    v_exp_f32 v38, v38
    v_lshlrev_b32 v50, 16, v29
    v_exp_f32 v39, v39
    v_and_b32 v51, 0xffff0000, v29
    v_exp_f32 v40, v40
    v_lshlrev_b32 v52, 16, v30
    v_exp_f32 v41, v41
    v_and_b32 v53, 0xffff0000, v30
    v_exp_f32 v42, v42
    v_lshlrev_b32 v54, 16, v31
    v_exp_f32 v43, v43
    v_and_b32 v55, 0xffff0000, v31
    v_mul_f32 v48, v48, v36
    v_mul_f32 v49, v49, v37
    v_add_f32 v13, v13, v36
    v_cvt_pk_bf16_f32 v44, v48, v49
    v_add_f32 v13, v13, v37
    v_mul_f32 v50, v50, v38
    v_mul_f32 v51, v51, v39
    v_add_f32 v13, v13, v38
    v_cvt_pk_bf16_f32 v45, v50, v51
    v_add_f32 v13, v13, v39
    v_mul_f32 v52, v52, v40
    v_mul_f32 v53, v53, v41
    v_add_f32 v13, v13, v40
    v_cvt_pk_bf16_f32 v46, v52, v53
    v_add_f32 v13, v13, v41
    v_mul_f32 v54, v54, v42
    v_mul_f32 v55, v55, v43
    v_add_f32 v13, v13, v42
    v_cvt_pk_bf16_f32 v47, v54, v55
    v_add_f32 v13, v13, v43
    v_add_u32 v4, 64, v4
    ds_read_b128 v[36:39], v16
    v_mfma_f32_16x16x32_bf16 v[112:115], v[44:47], v[32:35], v[112:115]
    ds_read_b128 v[40:43], v16 offset:1024
    ds_read_b128 v[28:31], v4
    s_waitcnt vmcnt(20)
    buffer_load_dwordx4 v[156:159], v2, s[24:27], 0 offen offset:2048 nt
    buffer_load_dwordx4 v[160:163], v2, s[24:27], 0 offen offset:2304 nt
    buffer_load_dwordx4 v[164:167], v2, s[24:27], 0 offen offset:2560 nt
    buffer_load_dwordx4 v[168:171], v2, s[24:27], 0 offen offset:2816 nt
    v_cvt_f32_i32 v188, v188
    v_cvt_f32_i32 v196, v196
    v_cvt_f32_i32 v189, v189
    v_cvt_f32_i32 v197, v197
    v_cvt_f32_i32 v190, v190
    v_cvt_f32_i32 v198, v198
    v_cvt_f32_i32 v191, v191
    v_cvt_f32_i32 v199, v199
    v_cvt_f32_i32 v192, v192
    v_cvt_f32_i32 v200, v200
    v_cvt_f32_i32 v193, v193
    v_cvt_f32_i32 v201, v201
    v_cvt_f32_i32 v194, v194
    v_cvt_f32_i32 v202, v202
    v_cvt_f32_i32 v195, v195
    v_cvt_f32_i32 v203, v203
    ds_read_b128 v[32:35], v4 offset:1024
    v_add_u32 v16, 2048, v16
    v_cvt_pk_bf16_f32 v48, v188, v196
    v_cvt_pk_bf16_f32 v52, v189, v197
    v_cvt_pk_bf16_f32 v56, v190, v198
    v_cvt_pk_bf16_f32 v60, v191, v199
    v_cvt_pk_bf16_f32 v64, v192, v200
    v_cvt_pk_bf16_f32 v68, v193, v201
    v_cvt_pk_bf16_f32 v72, v194, v202
    v_cvt_pk_bf16_f32 v76, v195, v203
    s_waitcnt vmcnt(20)
    buffer_load_dwordx4 v[172:175], v2, s[24:27], 0 offen offset:3072 nt
    buffer_load_dwordx4 v[176:179], v2, s[24:27], 0 offen offset:3328 nt
    buffer_load_dwordx4 v[180:183], v2, s[24:27], 0 offen offset:3584 nt
    buffer_load_dwordx4 v[184:187], v2, s[24:27], 0 offen offset:3840 nt
    v_cvt_f32_i32 v204, v204
    v_cvt_f32_i32 v212, v212
    v_cvt_f32_i32 v205, v205
    v_cvt_f32_i32 v213, v213
    v_cvt_f32_i32 v206, v206
    v_cvt_f32_i32 v214, v214
    v_cvt_f32_i32 v207, v207
    v_cvt_f32_i32 v215, v215
    v_cvt_f32_i32 v208, v208
    v_cvt_f32_i32 v216, v216
    v_cvt_f32_i32 v209, v209
    v_cvt_f32_i32 v217, v217
    v_cvt_f32_i32 v210, v210
    v_cvt_f32_i32 v218, v218
    v_cvt_f32_i32 v211, v211
    v_cvt_f32_i32 v219, v219
    v_cvt_pk_bf16_f32 v49, v204, v212
    v_cvt_pk_bf16_f32 v53, v205, v213
    v_cvt_pk_bf16_f32 v57, v206, v214
    v_cvt_pk_bf16_f32 v61, v207, v215
    v_cvt_pk_bf16_f32 v65, v208, v216
    v_cvt_pk_bf16_f32 v69, v209, v217
    v_cvt_pk_bf16_f32 v73, v210, v218
    v_cvt_pk_bf16_f32 v77, v211, v219
    s_waitcnt vmcnt(20)
    v_add_u32 v2, 1048576, v2
    buffer_load_dwordx4 v[188:191], v2, s[24:27], 0 offen offset:0 nt
    buffer_load_dwordx4 v[192:195], v2, s[24:27], 0 offen offset:256 nt
    buffer_load_dwordx4 v[196:199], v2, s[24:27], 0 offen offset:512 nt
    buffer_load_dwordx4 v[200:203], v2, s[24:27], 0 offen offset:768 nt
    v_cvt_f32_i32 v220, v220
    v_cvt_f32_i32 v228, v228
    v_cvt_f32_i32 v221, v221
    v_cvt_f32_i32 v229, v229
    v_cvt_f32_i32 v222, v222
    v_cvt_f32_i32 v230, v230
    v_cvt_f32_i32 v223, v223
    v_cvt_f32_i32 v231, v231
    v_cvt_f32_i32 v224, v224
    v_cvt_f32_i32 v232, v232
    v_cvt_f32_i32 v225, v225
    v_cvt_f32_i32 v233, v233
    v_cvt_f32_i32 v226, v226
    v_cvt_f32_i32 v234, v234
    v_cvt_f32_i32 v227, v227
    v_cvt_f32_i32 v235, v235
    v_cvt_pk_bf16_f32 v50, v220, v228
    v_cvt_pk_bf16_f32 v54, v221, v229
    v_cvt_pk_bf16_f32 v58, v222, v230
    v_cvt_pk_bf16_f32 v62, v223, v231
    v_cvt_pk_bf16_f32 v66, v224, v232
    v_cvt_pk_bf16_f32 v70, v225, v233
    v_cvt_pk_bf16_f32 v74, v226, v234
    v_cvt_pk_bf16_f32 v78, v227, v235
    s_waitcnt vmcnt(20)
    buffer_load_dwordx4 v[204:207], v2, s[24:27], 0 offen offset:1024 nt
    buffer_load_dwordx4 v[208:211], v2, s[24:27], 0 offen offset:1280 nt
    buffer_load_dwordx4 v[212:215], v2, s[24:27], 0 offen offset:1536 nt
    buffer_load_dwordx4 v[216:219], v2, s[24:27], 0 offen offset:1792 nt
    v_cvt_f32_i32 v236, v236
    v_cvt_f32_i32 v244, v244
    v_cvt_f32_i32 v237, v237
    v_cvt_f32_i32 v245, v245
    v_cvt_f32_i32 v238, v238
    v_cvt_f32_i32 v246, v246
    v_cvt_f32_i32 v239, v239
    v_cvt_f32_i32 v247, v247
    v_cvt_f32_i32 v240, v240
    v_cvt_f32_i32 v248, v248
    v_cvt_f32_i32 v241, v241
    v_cvt_f32_i32 v249, v249
    v_cvt_f32_i32 v242, v242
    v_cvt_f32_i32 v250, v250
    v_cvt_f32_i32 v243, v243
    v_cvt_f32_i32 v251, v251
    v_cvt_pk_bf16_f32 v51, v236, v244
    v_cvt_pk_bf16_f32 v55, v237, v245
    v_cvt_pk_bf16_f32 v59, v238, v246
    v_cvt_pk_bf16_f32 v63, v239, v247
    v_cvt_pk_bf16_f32 v67, v240, v248
    v_cvt_pk_bf16_f32 v71, v241, v249
    v_cvt_pk_bf16_f32 v75, v242, v250
    v_cvt_pk_bf16_f32 v79, v243, v251
    v_mfma_f32_16x16x32_bf16 v[80:83], v[44:47], v[48:51], v[80:83]
    v_mfma_f32_16x16x32_bf16 v[84:87], v[44:47], v[52:55], v[84:87]
    v_mfma_f32_16x16x32_bf16 v[88:91], v[44:47], v[56:59], v[88:91]
    v_mfma_f32_16x16x32_bf16 v[92:95], v[44:47], v[60:63], v[92:95]
    v_mfma_f32_16x16x32_bf16 v[96:99], v[44:47], v[64:67], v[96:99]
    v_mfma_f32_16x16x32_bf16 v[100:103], v[44:47], v[68:71], v[100:103]
    v_mfma_f32_16x16x32_bf16 v[104:107], v[44:47], v[72:75], v[104:107]
    v_mfma_f32_16x16x32_bf16 v[108:111], v[44:47], v[76:79], v[108:111]
    s_cmp_eq_u32 s42, 2
    s_cbranch_scc0 L_nosw2
    v_mov_b32 v19, v15
L_nosw2:
    s_add_u32 s42, s42, 2
    s_cmp_lt_u32 s42, 8
    s_cbranch_scc1 L_vloop
    v_mov_b32 v5, v13
    v_readfirstlane_b32 s48, v18
    s_nop 0
    v_permlane16_swap_b32 v13, v5
    v_add_f32 v13, v13, v5
    v_mov_b32 v5, v13
    s_cmp_eq_u32 s50, 0
    s_waitcnt lgkmcnt(0)
    v_permlane32_swap_b32 v13, v5
    v_add_f32 v45, v13, v5
    v_mov_b32 v44, v12
    s_cbranch_scc1 L_w0
    v_sub_f32 v40, v80, v112
    v_sub_f32 v41, v84, v112
    v_sub_f32 v42, v88, v112
    v_sub_f32 v43, v92, v112
    v_sub_f32 v36, v96, v112
    v_sub_f32 v37, v100, v112
    v_sub_f32 v38, v104, v112
    v_sub_f32 v39, v108, v112
    s_branch L_wx
L_w0:
    v_sub_f32 v40, v96, v112
    v_sub_f32 v41, v100, v112
    v_sub_f32 v42, v104, v112
    v_sub_f32 v43, v108, v112
    v_sub_f32 v36, v80, v112
    v_sub_f32 v37, v84, v112
    v_sub_f32 v38, v88, v112
    v_sub_f32 v39, v92, v112
L_wx:
    ds_write_b128 v122, v[40:43]
    s_mov_b64 exec, 0x1111
    ds_write_b64 v11, v[44:45]
    s_mov_b64 exec, -1
    s_and_b32 s55, s48, 0xff
    s_waitcnt lgkmcnt(0)
    s_barrier
    ds_read_b128 v[52:55], v117
    ds_read_b128 v[48:51], v123
    s_mov_b32 s43, 0xfffffffe
    s_waitcnt lgkmcnt(1)
    v_max_f32 v5, v52, v54
    v_sub_f32 v52, v52, v5
    v_sub_f32 v54, v54, v5
    v_exp_f32 v52, v52
    v_exp_f32 v54, v54
    v_min_u32 v44, s43, v5
    s_cmp_eq_u32 s50, 0
    v_mul_f32 v6, v52, v53
    v_fmac_f32 v6, v54, v55
    s_cbranch_scc1 L_f0
    v_swap_b32 v52, v54
L_f0:
    v_min_u32 v45, s43, v6
    s_waitcnt lgkmcnt(0)
    v_mul_f32 v36, v36, v52
    v_mul_f32 v37, v37, v52
    v_mul_f32 v38, v38, v52
    v_mul_f32 v39, v39, v52
    v_fmac_f32 v36, v48, v54
    v_fmac_f32 v37, v49, v54
    v_fmac_f32 v38, v50, v54
    v_fmac_f32 v39, v51, v54
    v_min_u32 v36, s43, v36
    v_min_u32 v37, s43, v37
    v_min_u32 v38, s43, v38
    v_min_u32 v39, s43, v39
    s_cmp_ge_u32 s55, 32
    s_cbranch_scc1 L_started
    s_mov_b32 s52, 0
    s_lshl_b32 s43, s40, 5
    v_mov_b32 v5, s43
L_spin0:
    global_load_dword v18, v5, s[20:21] sc1
    s_add_u32 s52, s52, 1
    s_waitcnt vmcnt(0)
    v_readfirstlane_b32 s48, v18
    s_cmp_gt_u32 s52, 262144
    s_cbranch_scc1 L_started
    s_nop 1
    s_and_b32 s55, s48, 0xff
    s_cmp_ge_u32 s55, 32
    s_cbranch_scc0 L_spin0
L_started:
    s_cmp_eq_u32 s48, s54
    s_cbranch_scc0 L_pslow
    global_store_dwordx4 v116, v[36:39], s[22:23]
    s_cmp_eq_u32 s50, 0
    s_cbranch_scc0 L_pdone
    s_mov_b32 exec_lo, 0x00010001
    s_mov_b32 exec_hi, 0x00010001
    global_store_dwordx2 v118, v[44:45], s[22:23]
    s_branch L_pdone
L_pslow:
    global_store_dwordx4 v116, v[36:39], s[22:23] sc1
    s_cmp_eq_u32 s50, 0
    s_cbranch_scc0 L_pdone
    s_mov_b32 exec_lo, 0x00010001
    s_mov_b32 exec_hi, 0x00010001
    global_store_dwordx2 v118, v[44:45], s[22:23] sc1
L_pdone:
    s_mov_b64 exec, -1
    s_mov_b32 s52, 0
L_poll:
    global_load_dwordx2 v[60:61], v120, s[22:23] sc1
    global_load_dwordx4 v[56:59], v119, s[22:23] sc1
    s_add_u32 s52, s52, 1
    s_cmp_gt_u32 s52, 262144
    s_cbranch_scc1 L_polled0
    s_waitcnt vmcnt(1)
    v_max_u32 v5, v60, v61
    v_max_f32_dpp v7, v60, v60 row_ror:2 row_mask:0xf bank_mask:0xf
    s_waitcnt vmcnt(0)
    v_max3_u32 v5, v5, v56, v57
    v_max_f32_dpp v7, v7, v7 row_ror:4 row_mask:0xf bank_mask:0xf
    v_max3_u32 v5, v5, v58, v59
    v_cmp_eq_u32 vcc, -1, v5
    v_max_f32_dpp v7, v7, v7 row_ror:8 row_mask:0xf bank_mask:0xf
    s_nop 3
    s_cbranch_vccnz L_poll
L_polled0:
    s_waitcnt vmcnt(0)
    v_mov_b32 v6, v7
    s_nop 1
    v_permlane16_swap_b32 v7, v6
    v_max_f32 v7, v7, v6
    v_mov_b32 v6, v7
    s_nop 1
    v_permlane32_swap_b32 v7, v6
    v_max_f32 v7, v7, v6
    v_sub_f32 v8, v60, v7
    v_exp_f32 v8, v8
    s_nop 0
    v_mul_f32 v61, v61, v8
    v_mul_f32 v56, v56, v8
    v_mul_f32 v57, v57, v8
    v_mul_f32 v58, v58, v8
    v_mul_f32 v59, v59, v8
    v_mov_b32 v64, v61
    v_permlane16_swap_b32 v56, v57
    v_permlane16_swap_b32 v58, v59
    v_permlane16_swap_b32 v61, v64
    v_add_f32 v56, v56, v57
    v_add_f32 v58, v58, v59
    v_add_f32 v61, v61, v64
    v_mov_b32 v64, v61
    v_permlane32_swap_b32 v56, v58
    s_nop 0
    v_permlane32_swap_b32 v61, v64
    v_add_f32 v56, v56, v58
    v_add_f32 v61, v61, v64
    s_nop 0
    v_add_f32_dpp v56, v56, v56 row_ror:2 row_mask:0xf bank_mask:0xf
    v_add_f32_dpp v61, v61, v61 row_ror:2 row_mask:0xf bank_mask:0xf
    s_nop 0
    v_add_f32_dpp v56, v56, v56 row_ror:4 row_mask:0xf bank_mask:0xf
    v_add_f32_dpp v61, v61, v61 row_ror:4 row_mask:0xf bank_mask:0xf
    s_nop 0
    v_add_f32_dpp v56, v56, v56 row_ror:8 row_mask:0xf bank_mask:0xf
    v_add_f32_dpp v61, v61, v61 row_ror:8 row_mask:0xf bank_mask:0xf
    v_rcp_f32 v10, v61
    s_mov_b32 exec_lo, 0x00030003
    s_mov_b32 exec_hi, 0x00030003
    v_mul_f32 v56, v56, v10
    v_cvt_pk_bf16_f32 v56, v56, v56
    global_store_short v121, v56, s[18:19]
L_send:
    s_endpgm
L_helper:
    s_lshl_b32 s43, s40, 5
    s_add_u32 s43, s43, s41
    s_lshl_b32 s43, s43, 11
    s_add_u32 s43, s43, 2097152
    v_lshlrev_b32 v20, 4, v1
    v_add_u32 v20, s43, v20
    v_lshlrev_b32 v21, 8, v5
    s_lshl_b32 s43, s40, 10
    s_lshl_b32 s48, s41, 3
    s_add_u32 s43, s43, s48
    s_add_u32 s43, s43, 4194304
    v_add_u32 v21, s43, v21
    v_mov_b32 v24, -1
    v_mov_b32 v25, -1
    v_mov_b32 v26, -1
    v_mov_b32 v27, -1
    s_getreg_b32 s53, hwreg(HW_REG_XCC_ID, 0, 4)
    s_mul_i32 s54, s53, s53
    s_lshl_b32 s54, s54, 18
    s_lshl_b32 s53, s53, 8
    s_add_u32 s53, s53, s54
    s_add_u32 s53, s53, 1
    s_lshl_b32 s43, s40, 5
    v_mov_b32 v28, s43
    v_mov_b32 v29, s53
    s_waitcnt lgkmcnt(0)
    global_store_dwordx4 v20, v[24:27], s[22:23] offset:0 sc1
    global_store_dwordx4 v20, v[24:27], s[22:23] offset:1024 sc1
    s_mov_b32 exec_lo, 0x00010001
    s_mov_b32 exec_hi, 0x00010001
    global_store_dwordx2 v21, v[24:25], s[22:23] sc1
    s_waitcnt vmcnt(0)
    s_mov_b64 exec, 1
    global_atomic_add v28, v29, s[20:21] sc1
L_hend:
L_end:
    s_endpgm
.section .rodata,"a"
.p2align 6
.amdhsa_kernel standalone__kv_cache_quant_int4_int2_kv_with_per_channel_or_per_token_scales__decode_kernel
  .amdhsa_next_free_vgpr 252
  .amdhsa_next_free_sgpr 96
  .amdhsa_accum_offset 252
  .amdhsa_group_segment_fixed_size 0
  .amdhsa_kernarg_size 80
  .amdhsa_user_sgpr_count 2
  .amdhsa_user_sgpr_kernarg_segment_ptr 1
  .amdhsa_system_sgpr_workgroup_id_x 1
.end_amdhsa_kernel
```
